```python
import torch

def _softmax(x, axis=-1):
    return torch.softmax(x, dim=axis)
def _gelu(x):
    return torch.nn.functional.gelu(x, approximate="tanh")
def _silu(x):
    return torch.nn.functional.silu(x)
def _sigmoid(x):
    return torch.sigmoid(x)
def _layernorm(x, axis=-1, eps=1e-5):
    m = x.mean(dim=axis, keepdim=True)
    v = x.var(dim=axis, keepdim=True, unbiased=False)
    return (x - m) / torch.sqrt(v + eps)
def _scatter_add(tgt, idx, src, axis=0):
    return tgt.clone().index_add_(axis, idx, src)
def _segment_sum(src, seg, n):
    out = torch.zeros((n,) + src.shape[1:], dtype=src.dtype)
    return out.index_add_(0, seg, src)
def _pad(x, pw):
    flat = tuple(v for pair in reversed(pw) for v in pair)
    return torch.nn.functional.pad(x, flat)

kernel_name = 'parallel_sum__sliding_block_cached__swiglu_ffn__decode'

def setup_inputs():

    _w = (lambda a: (lambda t: t.to(torch.bfloat16) if t.is_floating_point() else t)(torch.as_tensor(a)))
    def _A_setup():
        B, Sq, D = 1, 1, 512
        Hq, Hkv, Sk, Dh = 32, 8, 32768, 128
        assert Hq % Hkv == 0, (Hq, Hkv)
        return {
            "x": _w((lambda *s: torch.randn(*s, dtype=torch.bfloat16) * 0.05)(B, Sq, D)),
            "k_cache": _w((lambda *s: torch.randn(*s, dtype=torch.bfloat16) * 3.2)(B, Hkv, Sk, Dh)),
            "v_cache": _w((lambda *s: torch.randn(*s, dtype=torch.bfloat16) * 1.6)(B, Hkv, Sk, Dh)),
            "wq": _w((lambda *s: torch.randn(*s, dtype=torch.bfloat16) * 3.2)(D, Hq * Dh) * (D ** -0.5)),
            "wo": _w((lambda *s: torch.randn(*s, dtype=torch.bfloat16) * 1.6)(Hq * Dh, D) * ((Hq * Dh) ** -0.5)),
        }
    _A_in = _A_setup()

    def _B_setup():
        B, S, D, F = 1, 1, 512, 1792
        return {
            "x": _w((lambda *s: torch.randn(*s, dtype=torch.bfloat16) * 0.05)(B, S, D)),
            "w_gate": _w((lambda *s: torch.randn(*s, dtype=torch.bfloat16) * 0.05)(D, F)),
            "w_up": _w((lambda *s: torch.randn(*s, dtype=torch.bfloat16) * 0.05)(D, F)),
            "w_down": _w((lambda *s: torch.randn(*s, dtype=torch.bfloat16) * 0.05)(F, D)),
        }
    _B_in = _B_setup()

    return {
        "A_x": _A_in["x"],
        "A_k_cache": _A_in["k_cache"],
        "A_v_cache": _A_in["v_cache"],
        "A_wq": _A_in["wq"],
        "A_wo": _A_in["wo"],
        "B_x": _B_in["x"],
        "B_w_gate": _B_in["w_gate"],
        "B_w_up": _B_in["w_up"],
        "B_w_down": _B_in["w_down"],
    }

def reference(A_x, A_k_cache, A_v_cache, A_wq, A_wo, B_x, B_w_gate, B_w_up, B_w_down):
    def _A_ref(x, k_cache, v_cache, wq, wo):
        B, Sq, D = x.shape
        Hq, Dh = 32, 128
        Hkv, Sk = k_cache.shape[1], k_cache.shape[2]
        W = min(4096, max(256, Sk // 4))
        rep = Hq // Hkv
        q = (lambda x, *d: x.permute(*d))((x @ wq).reshape(B, Sq, Hq, Dh), 0, 2, 1, 3)
        k = (lambda x, n, axis: torch.repeat_interleave(x, n, dim=axis))(k_cache[:, :, Sk - W:, :], rep, axis=1)
        v = (lambda x, n, axis: torch.repeat_interleave(x, n, dim=axis))(v_cache[:, :, Sk - W:, :], rep, axis=1)
        scores = torch.einsum("bhqd,bhkd->bhqk", q, k) * (Dh ** -0.5)
        p = _softmax(scores, axis=-1)
        o = torch.einsum("bhqk,bhkd->bhqd", p, v)
        return (lambda x, *d: x.permute(*d))(o, 0, 2, 1, 3).reshape(B, Sq, Hq * Dh) @ wo

    def _B_ref(x, w_gate, w_up, w_down):
        g = _silu(x @ w_gate)
        u = x @ w_up
        return (g * u) @ w_down

    x = A_x
    xn = _layernorm(x, axis=-1)
    return x + _A_ref(xn, A_k_cache, A_v_cache, A_wq, A_wo) + _B_ref(xn, B_w_gate, B_w_up, B_w_down)
```

```asm
; @launch grid=(256,1,1) block=(256,1,1) lds=130512
.amdgcn_target "amdgcn-amd-amdhsa--gfx950"
.text
.globl parallel_sum__sliding_block_cached__swiglu_ffn__decode_kernel
.p2align 8
.type parallel_sum__sliding_block_cached__swiglu_ffn__decode_kernel,@function
parallel_sum__sliding_block_cached__swiglu_ffn__decode_kernel:
    s_load_dwordx16 s[64:79], s[0:1], 0
    s_load_dwordx8 s[80:87], s[0:1], 64
    s_cmp_ge_u32 s2, 256
    s_cbranch_scc1 L_end
    v_lshrrev_b32 v8, 6, v0
    v_and_b32 v1, 63, v0
    s_lshr_b32 s5, s2, 3
    v_readfirstlane_b32 s3, v8
    s_and_b32 s4, s2, 7
    s_cmp_ge_u32 s5, 2
    s_cbranch_scc1 L_nopf
    s_getpc_b64 s[90:91]
L_pfbase:
    v_lshlrev_b32 v8, 4, v0
    v_add_u32 v9, 4096, v8
    s_mov_b32 s56, L_end-L_pfbase-12
    v_min_u32 v8, s56, v8
    v_min_u32 v9, s56, v9
    global_load_dwordx4 v[88:91], v8, s[90:91]
    global_load_dwordx4 v[88:91], v9, s[90:91]
L_nopf:
    v_bfe_u32 v8, v1, 4, 1
    v_and_b32 v9, 7, v1
    v_lshlrev_b32 v8, 1, v8
    v_lshrrev_b32 v10, 3, v1
    v_xor_b32 v9, v8, v9
    v_lshlrev_b32 v7, 4, v1
    v_lshlrev_b32 v9, 4, v9
    s_lshr_b32 s48, s5, 3
    v_lshl_or_b32 v29, v10, 13, v9
    s_and_b32 s49, s5, 7
    v_xor_b32 v30, 64, v29
    s_lshl_b32 s58, s48, 20
    s_lshl_b32 s55, s3, 18
    s_add_u32 s58, s58, s55
    s_lshl_b32 s55, s4, 10
    s_add_u32 s58, s58, s55
    s_lshl_b32 s55, s49, 7
    s_add_u32 s58, s58, s55
    s_lshl_b32 s59, s3, 12
    s_add_u32 s59, s59, 106496
    s_mov_b32 s10, 1024
    s_mov_b32 s11, 0x20000
    s_mov_b32 s22, 4194304
    s_mov_b32 s23, 0x20000
    s_waitcnt lgkmcnt(0)
    s_mov_b32 s8, s64
    s_mov_b32 s9, s65
    s_mov_b32 s20, s70
    s_mov_b32 s21, s71
    buffer_load_dwordx4 v[12:15], v7, s[8:11], 0 offen
    s_add_u32 m0, s59, 0
    s_add_u32 s56, s58, 0
    buffer_load_dwordx4 v29, s[20:23], s56 offen nt lds
    s_add_u32 m0, s59, 1024
    s_add_u32 s56, s58, 65536
    buffer_load_dwordx4 v30, s[20:23], s56 offen nt lds
    s_add_u32 m0, s59, 2048
    s_add_u32 s56, s58, 131072
    buffer_load_dwordx4 v29, s[20:23], s56 offen nt lds
    s_add_u32 m0, s59, 3072
    s_add_u32 s56, s58, 196608
    buffer_load_dwordx4 v30, s[20:23], s56 offen nt lds
    s_barrier
    s_mov_b32 s42, 268435456
    s_mov_b32 s43, 0x20000
    s_mov_b32 s40, s86
    s_mov_b32 s41, s87
    v_mov_b32 v10, 0
    v_and_b32 v5, 3, v1
    s_and_b32 s56, s5, 15
    s_lshl_b32 s95, s4, 4
    s_add_u32 s95, s95, s56
    s_lshl_b32 s56, s95, 3
    v_lshl_add_u32 v11, v5, 1, s56
    buffer_load_dword v17, v10, s[40:43], 0 offen sc1
    buffer_load_ushort v16, v11, s[8:11], 0 offen
    v_lshrrev_b32 v2, 4, v1
    s_lshl_b32 s54, s4, 13
    s_lshl_b32 s55, s48, 11
    s_add_u32 s54, s54, s55
    s_lshl_b32 s55, s49, 8
    s_add_u32 s54, s54, s55
    s_lshl_b32 s55, s3, 6
    s_add_u32 s54, s54, s55
    v_lshl_add_u32 v62, v2, 4, s54
    s_lshl_b32 s54, s4, 9
    s_lshl_b32 s55, s5, 4
    s_add_u32 s54, s54, s55
    s_add_u32 s54, s54, 0x10000
    v_writelane_b32 v62, s54, 1
    s_cmp_eq_u32 s3, 0
    s_cselect_b32 s89, 2, 0
    s_or_b32 s89, s89, 0x00010001
    s_mov_b32 s57, 65536
    s_mov_b32 exec_lo, s89
    s_mov_b32 exec_hi, 0x00010001
    buffer_load_dwordx4 v[68:71], v62, s[40:43], s57 offen sc1 nt
    s_mov_b64 exec, -1
    v_and_b32 v3, 15, v1
    v_lshlrev_b32 v8, 1, v2
    v_xor_b32 v6, v8, v3
    v_lshlrev_b32 v6, 4, v6
    s_mul_i32 s54, s4, 28
    s_add_u32 s54, s54, s5
    s_mul_i32 s50, s54, 4682
    s_lshr_b32 s50, s50, 16
    s_mul_i32 s51, s50, 14
    s_sub_u32 s51, s54, s51
    s_and_b32 s94, s3, 1
    s_lshl_b32 s94, s94, 7
    s_movk_i32 s56, 3584
    v_xor_b32 v8, s94, v6
    v_mad_u32_u24 v31, v2, s56, v8
    s_lshl_b32 s60, s50, 5
    s_lshl_b32 s55, s3, 3
    s_add_u32 s60, s60, s55
    s_mul_i32 s60, s60, 3584
    s_lshl_b32 s55, s51, 8
    s_add_u32 s60, s60, s55
    s_lshl_b32 s61, s3, 11
    s_cmp_lt_u32 s5, 28
    s_cselect_b32 s30, 1835008, 0
    s_cselect_b32 s34, 1835008, 0
    s_mov_b32 s31, 0x20000
    s_mov_b32 s35, 0x20000
    s_mov_b32 s28, s76
    s_mov_b32 s29, s77
    s_mov_b32 s32, s78
    s_mov_b32 s33, s79
    s_add_u32 m0, s61, 32768
    s_add_u32 s56, s60, 0
    buffer_load_dwordx4 v31, s[28:31], s56 offen nt lds
    s_add_u32 m0, s61, 33792
    s_add_u32 s56, s60, 14336
    buffer_load_dwordx4 v31, s[28:31], s56 offen nt lds
    v_xor_b32 v8, v2, v3
    v_lshlrev_b32 v8, 4, v8
    v_lshl_or_b32 v37, v2, 8, v8
    v_xor_b32 v38, 64, v37
    s_lshl_b32 s62, s4, 23
    s_lshl_b32 s54, s5, 10
    s_add_u32 s62, s62, s54
    s_lshl_b32 s63, s3, 13
    s_lshl_b32 s54, s3, 15
    s_add_u32 s62, s62, s54
    s_add_u32 s62, s62, 0x700000
    s_mov_b32 s14, 67108864
    s_mov_b32 s15, 0x20000
    s_mov_b32 s12, s66
    s_mov_b32 s13, s67
    s_mov_b32 s16, s68
    s_mov_b32 s17, s69
    s_mov_b32 s18, 67108864
    s_mov_b32 s19, 0x20000
    s_mov_b32 s24, s72
    s_mov_b32 s25, s73
    s_mov_b32 s26, 4194304
    s_mov_b32 s27, 0x20000
    s_mov_b32 s36, s80
    s_mov_b32 s37, s81
    s_mov_b32 s38, 1835008
    s_mov_b32 s39, 0x20000
    s_mov_b32 s44, s82
    s_mov_b32 s45, s83
    s_mov_b32 s46, 1024
    s_mov_b32 s47, 0x20000
    v_bfe_u32 v4, v1, 2, 2
    v_xor_b32 v39, 128, v37
    v_xor_b32 v40, 192, v37
    v_lshl_add_u32 v11, v2, 3, v4
    v_lshlrev_b32 v8, 7, v11
    v_lshrrev_b32 v9, 1, v4
    v_and_b32 v10, 1, v2
    v_lshl_or_b32 v9, v10, 1, v9
    v_xor_b32 v9, s3, v9
    v_lshlrev_b32 v9, 1, v9
    v_lshrrev_b32 v10, 1, v5
    v_or_b32 v9, v9, v10
    v_lshl_or_b32 v8, v9, 4, v8
    v_and_b32 v10, 1, v5
    v_lshl_or_b32 v8, v10, 3, v8
    v_add_u32 v45, 106496, v8
    s_lshl_b32 s54, s48, 8
    s_add_u32 s54, s54, 122880
    v_lshl_add_u32 v46, v2, 4, s54
    s_lshl_b32 s54, s50, 6
    s_add_u32 s54, s54, 122880
    v_lshl_add_u32 v47, v2, 4, s54
    v_add_u32 v55, 122880, v7
    s_mov_b32 s64, s57
    s_lshl_b32 s54, s4, 13
    s_lshl_b32 s55, s3, 9
    s_add_u32 s54, s54, s55
    s_add_u32 s68, s54, 65536
    s_add_u32 s86, s68, 4096
    s_lshl_b32 s54, s4, 9
    s_add_u32 s101, s54, 131072
    v_mov_b32 v76, 0xffffff00
    s_getreg_b32 s83, hwreg(HW_REG_XCC_ID, 0, 3)
    s_waitcnt vmcnt(9)
    v_lshlrev_b32 v88, 16, v12
    v_and_b32 v89, 0xffff0000, v12
    v_lshlrev_b32 v90, 16, v13
    v_and_b32 v91, 0xffff0000, v13
    v_lshlrev_b32 v92, 16, v14
    v_and_b32 v93, 0xffff0000, v14
    v_lshlrev_b32 v94, 16, v15
    v_and_b32 v95, 0xffff0000, v15
    v_pk_add_f32 v[104:105], v[88:89], v[90:91]
    v_pk_add_f32 v[106:107], v[92:93], v[94:95]
    v_pk_add_f32 v[104:105], v[104:105], v[106:107]
    v_add_f32 v96, v104, v105
    s_nop 1
    v_add_f32_dpp v96, v96, v96 row_ror:8 row_mask:0xf bank_mask:0xf
    s_nop 1
    v_add_f32_dpp v96, v96, v96 row_ror:4 row_mask:0xf bank_mask:0xf
    s_nop 1
    v_add_f32_dpp v96, v96, v96 row_ror:2 row_mask:0xf bank_mask:0xf
    s_nop 1
    v_add_f32_dpp v96, v96, v96 row_ror:1 row_mask:0xf bank_mask:0xf
    v_mov_b32 v8, v96
    s_nop 1
    v_permlane16_swap_b32 v96, v8
    v_add_f32 v96, v96, v8
    v_mov_b32 v8, v96
    s_nop 1
    v_permlane32_swap_b32 v96, v8
    v_add_f32 v96, v96, v8
    v_mul_f32 v98, 0x3b000000, v96
    v_pk_add_f32 v[104:105], v[88:89], v[98:99] op_sel_hi:[1,0] neg_lo:[0,1] neg_hi:[0,1]
    v_pk_add_f32 v[106:107], v[90:91], v[98:99] op_sel_hi:[1,0] neg_lo:[0,1] neg_hi:[0,1]
    v_pk_add_f32 v[108:109], v[92:93], v[98:99] op_sel_hi:[1,0] neg_lo:[0,1] neg_hi:[0,1]
    v_pk_add_f32 v[110:111], v[94:95], v[98:99] op_sel_hi:[1,0] neg_lo:[0,1] neg_hi:[0,1]
    v_pk_mul_f32 v[112:113], v[104:105], v[104:105]
    v_pk_fma_f32 v[112:113], v[106:107], v[106:107], v[112:113]
    v_pk_fma_f32 v[112:113], v[108:109], v[108:109], v[112:113]
    v_pk_fma_f32 v[112:113], v[110:111], v[110:111], v[112:113]
    v_add_f32 v97, v112, v113
    s_nop 1
    v_add_f32_dpp v97, v97, v97 row_ror:8 row_mask:0xf bank_mask:0xf
    s_nop 1
    v_add_f32_dpp v97, v97, v97 row_ror:4 row_mask:0xf bank_mask:0xf
    s_nop 1
    v_add_f32_dpp v97, v97, v97 row_ror:2 row_mask:0xf bank_mask:0xf
    s_nop 1
    v_add_f32_dpp v97, v97, v97 row_ror:1 row_mask:0xf bank_mask:0xf
    v_mov_b32 v8, v97
    s_nop 1
    v_permlane16_swap_b32 v97, v8
    v_add_f32 v97, v97, v8
    v_mov_b32 v8, v97
    s_nop 1
    v_permlane32_swap_b32 v97, v8
    v_add_f32 v97, v97, v8
    v_mul_f32 v97, 0x3b000000, v97
    v_cvt_pk_bf16_f32 v8, v97, v98
    v_and_b32 v98, 0xffff0000, v8
    v_lshlrev_b32 v97, 16, v8
    v_add_f32 v97, 925353388, v97
    v_cvt_pk_bf16_f32 v8, v97, v97
    v_lshlrev_b32 v97, 16, v8
    v_sqrt_f32 v97, v97
    s_nop 0
    v_cvt_pk_bf16_f32 v8, v97, v97
    v_lshlrev_b32 v102, 16, v8
    v_rcp_f32 v100, v102
    s_nop 0
    v_fma_f32 v8, -v102, v100, 1.0
    v_fma_f32 v100, v8, v100, v100
    v_pk_add_f32 v[104:105], v[88:89], v[98:99] op_sel_hi:[1,0] neg_lo:[0,1] neg_hi:[0,1]
    v_pk_add_f32 v[106:107], v[90:91], v[98:99] op_sel_hi:[1,0] neg_lo:[0,1] neg_hi:[0,1]
    v_pk_add_f32 v[108:109], v[92:93], v[98:99] op_sel_hi:[1,0] neg_lo:[0,1] neg_hi:[0,1]
    v_pk_add_f32 v[110:111], v[94:95], v[98:99] op_sel_hi:[1,0] neg_lo:[0,1] neg_hi:[0,1]
    v_cvt_pk_bf16_f32 v8, v104, v105
    v_lshlrev_b32 v104, 16, v8
    v_and_b32 v105, 0xffff0000, v8
    v_cvt_pk_bf16_f32 v9, v106, v107
    v_lshlrev_b32 v106, 16, v9
    v_and_b32 v107, 0xffff0000, v9
    v_cvt_pk_bf16_f32 v8, v108, v109
    v_lshlrev_b32 v108, 16, v8
    v_and_b32 v109, 0xffff0000, v8
    v_cvt_pk_bf16_f32 v9, v110, v111
    v_lshlrev_b32 v110, 16, v9
    v_and_b32 v111, 0xffff0000, v9
    v_pk_mul_f32 v[88:89], v[104:105], v[100:101] op_sel_hi:[1,0]
    v_pk_mul_f32 v[90:91], v[106:107], v[100:101] op_sel_hi:[1,0]
    v_pk_mul_f32 v[92:93], v[108:109], v[100:101] op_sel_hi:[1,0]
    v_pk_mul_f32 v[94:95], v[110:111], v[100:101] op_sel_hi:[1,0]
    v_pk_fma_f32 v[104:105], v[88:89], v[102:103], v[104:105] op_sel_hi:[1,0,1] neg_lo:[1,0,0] neg_hi:[1,0,0]
    v_pk_fma_f32 v[106:107], v[90:91], v[102:103], v[106:107] op_sel_hi:[1,0,1] neg_lo:[1,0,0] neg_hi:[1,0,0]
    v_pk_fma_f32 v[108:109], v[92:93], v[102:103], v[108:109] op_sel_hi:[1,0,1] neg_lo:[1,0,0] neg_hi:[1,0,0]
    v_pk_fma_f32 v[110:111], v[94:95], v[102:103], v[110:111] op_sel_hi:[1,0,1] neg_lo:[1,0,0] neg_hi:[1,0,0]
    v_pk_fma_f32 v[88:89], v[104:105], v[100:101], v[88:89] op_sel_hi:[1,0,1]
    v_pk_fma_f32 v[90:91], v[106:107], v[100:101], v[90:91] op_sel_hi:[1,0,1]
    v_pk_fma_f32 v[92:93], v[108:109], v[100:101], v[92:93] op_sel_hi:[1,0,1]
    v_pk_fma_f32 v[94:95], v[110:111], v[100:101], v[94:95] op_sel_hi:[1,0,1]
    v_cvt_pk_bf16_f32 v112, v88, v89
    v_cvt_pk_bf16_f32 v113, v90, v91
    v_cvt_pk_bf16_f32 v114, v92, v93
    v_cvt_pk_bf16_f32 v115, v94, v95
    ds_write_b128 v55, v[112:115]
    s_add_u32 m0, s61, 40960
    s_add_u32 s56, s60, 0
    buffer_load_dwordx4 v31, s[32:35], s56 offen nt lds
    s_waitcnt lgkmcnt(0)
    ds_read_b128 v[120:123], v46 offset:0
    ds_read_b128 v[124:127], v46 offset:64
    ds_read_b128 v[128:131], v46 offset:128
    ds_read_b128 v[132:135], v46 offset:192
    ds_read_b128 v[136:139], v47
    s_waitcnt vmcnt(9)
    s_waitcnt vmcnt(8)
    s_waitcnt vmcnt(7)
    s_add_u32 m0, s61, 41984
    s_add_u32 s56, s60, 14336
    buffer_load_dwordx4 v31, s[32:35], s56 offen nt lds
    s_waitcnt vmcnt(7)
    s_add_u32 m0, s63, 73728
    s_add_u32 s56, s62, 0
    buffer_load_dwordx4 v37, s[12:15], s56 offen nt lds
    s_waitcnt vmcnt(5)
    v_readfirstlane_b32 s6, v17
    s_and_b32 s6, s6, 0xfffffff8
    s_mul_i32 s6, s6, 625341585
    s_add_u32 s6, s6, 2654435768
    s_xor_b32 s80, s6, s83
    s_and_b32 s58, s80, 0xff
    s_bfe_u32 s59, s6, 0x80008
    s_bfe_u32 s60, s6, 0x80010
    s_lshr_b32 s61, s6, 24
    s_barrier
    ds_read_b64_tr_b16 v[140:141], v45 offset:0
    ds_read_b64_tr_b16 v[142:143], v45 offset:512
    ds_read_b64_tr_b16 v[144:145], v45 offset:4096
    ds_read_b64_tr_b16 v[146:147], v45 offset:4608
    ds_read_b64_tr_b16 v[148:149], v45 offset:8192
    ds_read_b64_tr_b16 v[150:151], v45 offset:8704
    ds_read_b64_tr_b16 v[152:153], v45 offset:12288
    ds_read_b64_tr_b16 v[154:155], v45 offset:12800
    s_waitcnt lgkmcnt(6)
    v_mfma_f32_16x16x32_bf16 v[156:159], v[140:143], v[120:123], 0
    s_waitcnt lgkmcnt(4)
    v_mfma_f32_16x16x32_bf16 v[156:159], v[144:147], v[124:127], v[156:159]
    s_waitcnt lgkmcnt(2)
    v_mfma_f32_16x16x32_bf16 v[156:159], v[148:151], v[128:131], v[156:159]
    s_waitcnt lgkmcnt(0)
    v_mfma_f32_16x16x32_bf16 v[156:159], v[152:155], v[132:135], v[156:159]
    v_lshlrev_b32 v8, 8, v11
    v_and_b32 v9, 1, v2
    v_lshlrev_b32 v9, 3, v9
    v_lshl_or_b32 v9, v4, 1, v9
    v_lshrrev_b32 v10, 1, v5
    v_or_b32 v9, v9, v10
    v_lshl_or_b32 v8, v9, 4, v8
    v_and_b32 v10, 1, v5
    v_lshl_or_b32 v8, v10, 3, v8
    v_bfi_b32 v68, v76, v156, s58
    v_bfi_b32 v69, v76, v157, s59
    v_bfi_b32 v70, v76, v158, s60
    v_bfi_b32 v71, v76, v159, s61
    v_writelane_b32 v68, s80, 1
    s_mov_b32 exec_lo, s89
    s_mov_b32 exec_hi, 0x00010001
    buffer_store_dwordx4 v[68:71], v62, s[40:43], s64 offen
    s_mov_b64 exec, -1
    s_add_u32 m0, s63, 74752
    s_add_u32 s56, s62, 131072
    buffer_load_dwordx4 v37, s[12:15], s56 offen nt lds
    s_lshl_b32 s54, s3, 6
    v_xor_b32 v41, s54, v8
    v_xor_b32 v42, 32, v41
    v_add_u32 v43, 32768, v41
    v_add_u32 v44, 32768, v42
    v_lshl_or_b32 v32, v2, 8, v6
    v_xor_b32 v33, 128, v32
    s_mul_i32 s54, s50, 28672
    s_lshl_b32 s55, s51, 11
    s_add_u32 s54, s54, s55
    s_lshl_b32 s55, s3, 9
    s_add_u32 s54, s54, s55
    s_add_u32 s54, s54, 262144
    s_lshl_b32 s56, s2, 11
    s_add_u32 s56, s56, s55
    s_add_u32 s56, s56, 3145728
    s_cmp_lt_u32 s5, 28
    s_cselect_b32 s66, s54, s56
    s_waitcnt vmcnt(6)
    s_waitcnt vmcnt(5)
    s_add_u32 m0, s63, 75776
    s_add_u32 s56, s62, 262144
    buffer_load_dwordx4 v38, s[12:15], s56 offen nt lds
    s_waitcnt vmcnt(5)
    s_add_u32 m0, s63, 76800
    s_add_u32 s56, s62, 393216
    buffer_load_dwordx4 v38, s[12:15], s56 offen nt lds
    s_waitcnt vmcnt(5)
    s_add_u32 m0, s63, 77824
    s_add_u32 s56, s62, 524288
    buffer_load_dwordx4 v39, s[12:15], s56 offen nt lds
    s_barrier
    ds_read_b64_tr_b16 v[160:161], v43 offset:0
    ds_read_b64_tr_b16 v[162:163], v43 offset:1024
    ds_read_b64_tr_b16 v[164:165], v44 offset:0
    ds_read_b64_tr_b16 v[166:167], v44 offset:1024
    ds_read_b64_tr_b16 v[168:169], v43 offset:8192
    ds_read_b64_tr_b16 v[170:171], v43 offset:9216
    ds_read_b64_tr_b16 v[172:173], v44 offset:8192
    ds_read_b64_tr_b16 v[174:175], v44 offset:9216
    v_cmp_lt_u32 vcc, 15, v1
    v_mov_b32 v86, s6
    v_mov_b32 v87, 0
    s_waitcnt lgkmcnt(6)
    v_mfma_f32_16x16x32_bf16 v[176:179], v[136:139], v[160:163], 0
    s_waitcnt lgkmcnt(4)
    v_mfma_f32_16x16x32_bf16 v[180:183], v[136:139], v[164:167], 0
    s_waitcnt lgkmcnt(2)
    v_mfma_f32_16x16x32_bf16 v[184:187], v[136:139], v[168:171], 0
    s_waitcnt lgkmcnt(0)
    v_mfma_f32_16x16x32_bf16 v[188:191], v[136:139], v[172:175], 0
    v_lshlrev_b32 v8, 15, v5
    v_lshrrev_b32 v9, 1, v4
    v_lshl_or_b32 v8, v9, 12, v8
    v_lshl_or_b32 v8, v2, 5, v8
    v_and_b32 v9, 1, v4
    v_lshl_or_b32 v63, v9, 4, v8
    s_lshl_b32 s54, s4, 17
    s_add_u32 s54, s54, 1048576
    s_add_u32 s55, s54, s63
    s_lshl_b32 s56, s5, 7
    s_add_u32 s65, s55, s56
    v_cndmask_b32 v84, v176, v180, vcc
    v_cndmask_b32 v85, v184, v188, vcc
    s_mov_b32 exec_hi, 0
    buffer_store_dwordx4 v[84:87], v7, s[40:43], s66 offen sc1
    s_mov_b64 exec, -1
    s_add_u32 m0, s63, 78848
    s_add_u32 s56, s62, 655360
    buffer_load_dwordx4 v39, s[12:15], s56 offen nt lds
    buffer_load_dwordx4 v[80:83], v63, s[40:43], s65 offen sc1 nt
    s_lshr_b32 s55, s5, 3
    s_lshl_b32 s55, s55, 15
    s_add_u32 s54, s54, s55
    s_bfe_u32 s55, s5, 0x10002
    s_lshl_b32 s55, s55, 2
    s_add_u32 s55, s55, s3
    s_lshl_b32 s55, s55, 12
    s_add_u32 s71, s54, s55
    v_lshrrev_b32 v8, 2, v1
    v_lshlrev_b32 v8, 11, v8
    v_lshl_or_b32 v66, v5, 4, v8
    s_lshr_b32 s54, s95, 5
    s_lshl_b32 s54, s54, 17
    s_and_b32 s55, s95, 31
    s_lshl_b32 s55, s55, 6
    s_add_u32 s54, s54, s55
    s_add_u32 s72, s54, 2097152
    s_add_u32 s73, s72, 32768
    s_add_u32 s74, s72, 65536
    s_add_u32 s75, s72, 98304
    v_lshrrev_b32 v8, 5, v1
    v_and_b32 v9, 31, v1
    v_lshlrev_b32 v9, 4, v9
    v_lshl_or_b32 v64, v8, 11, v9
    v_lshrrev_b32 v9, 1, v9
    v_lshl_or_b32 v10, v8, 2, v9
    s_mul_i32 s54, s3, 320
    s_add_u32 s54, s54, 123904
    v_add_u32 v56, s54, v10
    v_lshl_add_u32 v8, v4, 3, v5
    v_lshlrev_b32 v8, 8, v8
    v_xor_b32 v9, v2, v3
    v_lshl_or_b32 v8, v9, 4, v8
    s_add_u32 s54, s63, 73728
    v_add_u32 v51, s54, v8
    v_xor_b32 v52, 64, v51
    v_xor_b32 v53, 128, v51
    v_xor_b32 v54, 192, v51
    v_mul_u32_u24 v8, 320, v5
    v_lshl_add_u32 v8, v2, 4, v8
    v_add_u32 v48, 123904, v8
    v_add_u32 v49, 126208, v7
    v_lshlrev_b32 v8, 4, v2
    v_add_u32 v50, 130304, v8
    s_lshl_b32 s54, s3, 8
    s_add_u32 s54, s54, 125184
    v_lshl_add_u32 v57, v1, 2, s54
    v_lshlrev_b32 v8, 2, v1
    v_add_u32 v58, 125184, v8
    s_lshl_b32 s54, s3, 10
    v_add_u32 v59, s54, v49
    v_lshl_or_b32 v34, v2, 10, v6
    s_lshr_b32 s54, s3, 1
    s_lshl_b32 s54, s54, 7
    v_xor_b32 v35, s54, v34
    v_xor_b32 v36, s94, v34
    s_lshl_b32 s52, s4, 3
    s_lshr_b32 s54, s5, 2
    s_add_u32 s52, s52, s54
    s_and_b32 s53, s5, 3
    s_lshl_b32 s90, s52, 6
    s_lshl_b32 s55, s3, 2
    s_add_u32 s90, s90, s55
    s_lshl_b32 s90, s90, 10
    s_lshl_b32 s55, s53, 8
    s_add_u32 s90, s90, s55
    s_lshl_b32 s91, s3, 10
    s_mul_i32 s54, s52, 28
    s_lshl_b32 s54, s54, 10
    s_add_u32 s54, s54, s55
    s_lshl_b32 s55, s3, 3
    s_min_u32 s56, s55, 24
    s_lshl_b32 s56, s56, 10
    s_add_u32 s92, s54, s56
    s_add_u32 s55, s55, 4
    s_min_u32 s56, s55, 24
    s_lshl_b32 s56, s56, 10
    s_add_u32 s100, s54, s56
    s_lshl_b32 s93, s3, 11
    s_xor_b32 s81, s6, s83
    s_waitcnt vmcnt(8)
    s_waitcnt vmcnt(6)
    s_add_u32 m0, s63, 79872
    s_add_u32 s56, s62, 786432
    buffer_load_dwordx4 v40, s[12:15], s56 offen nt lds
    s_waitcnt vmcnt(6)
    s_add_u32 m0, s63, 80896
    s_add_u32 s56, s62, 917504
    buffer_load_dwordx4 v40, s[12:15], s56 offen nt lds
    v_and_b32 v129, 31, v1
    v_lshlrev_b32 v129, 4, v129
    buffer_load_dwordx4 v[120:123], v64, s[40:43], s68 offen sc1
    buffer_load_dwordx4 v[124:127], v64, s[40:43], s86 offen sc1
    buffer_load_dword v128, v129, s[40:43], s101 offen sc1
    s_add_u32 m0, s63, 0
    s_add_u32 s56, s62, 0
    buffer_load_dwordx4 v32, s[16:19], s56 offen nt lds
    v_and_b32 v9, 7, v1
    v_min_u32 v10, 6, v9
    s_mul_i32 s54, s3, 14
    s_add_u32 s54, s54, 130432
    v_lshl_add_u32 v60, v10, 1, s54
    v_lshlrev_b32 v10, 4, v10
    v_lshrrev_b32 v8, 3, v1
    s_movk_i32 s54, 28672
    v_mad_u32_u24 v65, v8, s54, v10
    v_and_b32 v10, 1, v2
    v_lshlrev_b32 v10, 1, v10
    v_lshl_or_b32 v9, v9, 2, v10
    s_lshl_b32 s54, s3, 5
    s_add_u32 s54, s54, 130304
    v_add_u32 v61, s54, v9
    s_lshl_b32 s54, s53, 6
    s_add_u32 s54, s54, s52
    s_lshl_b32 s54, s54, 11
    s_lshl_b32 s55, s3, 9
    s_add_u32 s54, s54, s55
    s_add_u32 s67, s54, 2097152
    s_mul_i32 s69, s52, 28
    s_mul_i32 s55, s3, 7
    s_add_u32 s69, s69, s55
    s_lshl_b32 s69, s69, 4
    s_add_u32 s69, s69, 262144
    s_add_u32 s70, s69, 229376
    s_mov_b32 s96, 0xf0f0f0f0
    s_mov_b32 s97, 0xf0f0f0f0
    s_mov_b32 s98, 0xff00ff00
    s_mov_b32 s99, 0xff00ff00
    s_mov_b32 s76, 1035273459
    s_mov_b32 s77, 1035273459
    s_mov_b32 s78, 1069066811
    s_mov_b32 s79, 1069066811
    v_mov_b32 v9, 0
    v_mov_b32 v10, 130432
    ds_write_b32 v10, v9 offset:56
    ds_write_b32 v10, v9 offset:60
    s_waitcnt vmcnt(10)
    s_waitcnt vmcnt(9)
    s_add_u32 m0, s63, 1024
    s_add_u32 s56, s62, 131072
    buffer_load_dwordx4 v32, s[16:19], s56 offen nt lds
    s_waitcnt vmcnt(8)
    s_add_u32 m0, s63, 2048
    s_add_u32 s56, s62, 262144
    buffer_load_dwordx4 v33, s[16:19], s56 offen nt lds
    s_waitcnt vmcnt(7)
    s_add_u32 m0, s63, 3072
    s_add_u32 s56, s62, 393216
    buffer_load_dwordx4 v33, s[16:19], s56 offen nt lds
    s_waitcnt vmcnt(7)
    s_add_u32 m0, s63, 4096
    s_add_u32 s56, s62, 524288
    buffer_load_dwordx4 v32, s[16:19], s56 offen nt lds
    ds_read_b128 v[152:155], v51
    ds_read_b128 v[168:171], v51 offset:1024
    ds_read_b128 v[156:159], v52
    ds_read_b128 v[172:175], v52 offset:1024
    ds_read_b128 v[160:163], v53
    ds_read_b128 v[176:179], v53 offset:1024
    ds_read_b128 v[164:167], v54
    ds_read_b128 v[180:183], v54 offset:1024
    s_waitcnt vmcnt(5)
    v_xor_b32 v9, s58, v120
    v_xor_b32 v18, s59, v121
    v_xor_b32 v10, s81, v128
    v_bitop3_b32 v9, v124, v9, s58 bitop3:0xde
    v_bitop3_b32 v18, v125, v18, s59 bitop3:0xde
    v_bitop3_b32 v18, v122, v18, s60 bitop3:0xde
    v_bitop3_b32 v18, v126, v18, s60 bitop3:0xde
    v_bitop3_b32 v18, v123, v18, s61 bitop3:0xde
    v_bitop3_b32 v18, v127, v18, s61 bitop3:0xde
    v_and_b32 v9, 0xff, v9
    v_and_b32 v18, 0xff, v18
    v_or_b32 v9, v9, v10
    v_and_b32 v10, 0xfffffff8, v9
    v_or_b32 v18, v18, v10
    v_cmp_ne_u32 vcc, 0, v18
    s_mov_b32 s7, 0
    s_cbranch_vccz L_ok_q
L_rt_q:
    s_add_u32 s7, s7, 1
    s_cmp_gt_u32 s7, 100000
    s_cbranch_scc1 L_ok_q
    s_cmp_lg_u32 s7, 5
    s_cbranch_scc1 L_nb_q
    s_xor_b32 s54, s64, 4194304
    s_mov_b32 exec_lo, s89
    s_mov_b32 exec_hi, 0x00010001
    buffer_store_dwordx4 v[68:71], v62, s[40:43], s54 offen sc1
    s_mov_b64 exec, -1
L_nb_q:
    s_cmp_ge_u32 s7, 5
    s_cselect_b32 s54, 4194304, 0
    s_xor_b32 s68, s68, s54
    s_xor_b32 s86, s86, s54
    s_xor_b32 s101, s101, s54
    buffer_load_dwordx4 v[120:123], v64, s[40:43], s68 offen sc1
    buffer_load_dwordx4 v[124:127], v64, s[40:43], s86 offen sc1
    buffer_load_dword v128, v129, s[40:43], s101 offen sc1
    s_waitcnt vmcnt(0)
    v_xor_b32 v9, s58, v120
    v_xor_b32 v18, s59, v121
    v_xor_b32 v10, s81, v128
    v_bitop3_b32 v9, v124, v9, s58 bitop3:0xde
    v_bitop3_b32 v18, v125, v18, s59 bitop3:0xde
    v_bitop3_b32 v18, v122, v18, s60 bitop3:0xde
    v_bitop3_b32 v18, v126, v18, s60 bitop3:0xde
    v_bitop3_b32 v18, v123, v18, s61 bitop3:0xde
    v_bitop3_b32 v18, v127, v18, s61 bitop3:0xde
    v_and_b32 v9, 0xff, v9
    v_and_b32 v18, 0xff, v18
    v_or_b32 v9, v9, v10
    v_and_b32 v10, 0xfffffff8, v9
    v_or_b32 v18, v18, v10
    v_cmp_ne_u32 vcc, 0, v18
    s_cbranch_vccnz L_rt_q
L_ok_q:
    v_cmp_ne_u32 vcc, 0, v9
    v_and_b32 v120, v76, v120
    v_and_b32 v121, v76, v121
    s_cmp_eq_u64 vcc, 0
    s_cselect_b32 s82, 1, 0
    s_cbranch_scc1 L_coloc
    s_xor_b32 s54, s64, 4194304
    s_mov_b32 exec_lo, s89
    s_mov_b32 exec_hi, 0x00010001
    buffer_store_dwordx4 v[68:71], v62, s[40:43], s54 offen sc1
    s_mov_b64 exec, -1
    s_waitcnt vmcnt(0)
L_coloc:
    s_add_u32 m0, s63, 5120
    s_add_u32 s56, s62, 655360
    buffer_load_dwordx4 v32, s[16:19], s56 offen nt lds
    v_and_b32 v122, v76, v122
    v_and_b32 v123, v76, v123
    v_and_b32 v124, v76, v124
    v_and_b32 v125, v76, v125
    v_and_b32 v126, v76, v126
    v_and_b32 v127, v76, v127
    v_pk_add_f32 v[120:121], v[120:121], v[124:125]
    v_pk_add_f32 v[122:123], v[122:123], v[126:127]
    s_nop 1
    v_permlane32_swap_b32 v120, v122
    v_permlane32_swap_b32 v121, v123
    v_pk_add_f32 v[120:121], v[120:121], v[122:123]
    v_cvt_pk_bf16_f32 v8, v120, v121
    ds_write_b32 v56, v8
    s_waitcnt lgkmcnt(0)
    s_barrier
    ds_read_b128 v[184:187], v48 offset:0
    ds_read_b128 v[188:191], v48 offset:64
    ds_read_b128 v[192:195], v48 offset:128
    ds_read_b128 v[196:199], v48 offset:192
    s_add_u32 m0, s63, 6144
    s_add_u32 s56, s62, 786432
    buffer_load_dwordx4 v33, s[16:19], s56 offen nt lds
    s_waitcnt lgkmcnt(3)
    v_mfma_f32_16x16x32_bf16 v[200:203], v[152:155], v[184:187], 0
    v_mfma_f32_16x16x32_bf16 v[204:207], v[168:171], v[184:187], 0
    s_waitcnt lgkmcnt(2)
    v_mfma_f32_16x16x32_bf16 v[200:203], v[156:159], v[188:191], v[200:203]
    v_mfma_f32_16x16x32_bf16 v[204:207], v[172:175], v[188:191], v[204:207]
    s_waitcnt lgkmcnt(1)
    v_mfma_f32_16x16x32_bf16 v[200:203], v[160:163], v[192:195], v[200:203]
    v_mfma_f32_16x16x32_bf16 v[204:207], v[176:179], v[192:195], v[204:207]
    s_waitcnt lgkmcnt(0)
    v_mfma_f32_16x16x32_bf16 v[200:203], v[164:167], v[196:199], v[200:203]
    v_mfma_f32_16x16x32_bf16 v[204:207], v[180:183], v[196:199], v[204:207]
    s_nop 6
    v_cvt_pk_bf16_f32 v128, v200, v201
    v_cvt_pk_bf16_f32 v129, v202, v203
    v_cvt_pk_bf16_f32 v130, v204, v205
    v_cvt_pk_bf16_f32 v131, v206, v207
    v_lshlrev_b32 v120, 16, v128
    v_and_b32 v121, 0xffff0000, v128
    v_lshlrev_b32 v122, 16, v129
    v_and_b32 v123, 0xffff0000, v129
    v_lshlrev_b32 v124, 16, v130
    v_and_b32 v125, 0xffff0000, v130
    v_lshlrev_b32 v126, 16, v131
    v_and_b32 v127, 0xffff0000, v131
    v_pk_mul_f32 v[120:121], v[120:121], s[76:77]
    v_pk_mul_f32 v[122:123], v[122:123], s[76:77]
    v_pk_mul_f32 v[124:125], v[124:125], s[76:77]
    v_pk_mul_f32 v[126:127], v[126:127], s[76:77]
    v_cvt_pk_bf16_f32 v128, v120, v121
    v_cvt_pk_bf16_f32 v129, v122, v123
    v_cvt_pk_bf16_f32 v130, v124, v125
    v_cvt_pk_bf16_f32 v131, v126, v127
    v_lshlrev_b32 v120, 16, v128
    v_and_b32 v121, 0xffff0000, v128
    v_lshlrev_b32 v122, 16, v129
    v_and_b32 v123, 0xffff0000, v129
    v_lshlrev_b32 v124, 16, v130
    v_and_b32 v125, 0xffff0000, v130
    v_lshlrev_b32 v126, 16, v131
    v_and_b32 v127, 0xffff0000, v131
    v_max3_f32 v19, v120, v121, v122
    v_max3_f32 v8, v123, v124, v125
    v_max3_f32 v19, v126, v127, v19
    v_max_f32 v19, v19, v8
    v_mov_b32 v8, v19
    s_nop 1
    v_permlane16_swap_b32 v19, v8
    v_max_f32 v19, v19, v8
    v_mov_b32 v8, v19
    s_nop 1
    v_permlane32_swap_b32 v19, v8
    v_max_f32 v19, v19, v8
    ds_write_b32 v57, v19
    s_add_u32 m0, s63, 7168
    s_add_u32 s56, s62, 917504
    buffer_load_dwordx4 v33, s[16:19], s56 offen nt lds
    s_waitcnt lgkmcnt(0)
    s_barrier
    ds_read2st64_b32 v[128:129], v58 offset0:0 offset1:1
    ds_read2st64_b32 v[130:131], v58 offset0:2 offset1:3
    buffer_load_dwordx4 v[136:139], v65, s[40:43], s69 offen sc1
    buffer_load_dwordx4 v[140:143], v65, s[40:43], s70 offen sc1
    s_waitcnt lgkmcnt(0)
    v_max3_f32 v19, v128, v129, v130
    v_max_f32 v19, v19, v131
    v_mul_f32 v132, s78, v19
    v_pk_fma_f32 v[120:121], v[120:121], s[78:79], v[132:133] op_sel_hi:[1,1,0] neg_lo:[0,0,1] neg_hi:[0,0,1]
    v_pk_fma_f32 v[122:123], v[122:123], s[78:79], v[132:133] op_sel_hi:[1,1,0] neg_lo:[0,0,1] neg_hi:[0,0,1]
    v_pk_fma_f32 v[124:125], v[124:125], s[78:79], v[132:133] op_sel_hi:[1,1,0] neg_lo:[0,0,1] neg_hi:[0,0,1]
    v_pk_fma_f32 v[126:127], v[126:127], s[78:79], v[132:133] op_sel_hi:[1,1,0] neg_lo:[0,0,1] neg_hi:[0,0,1]
    v_exp_f32 v120, v120
    v_exp_f32 v121, v121
    v_exp_f32 v122, v122
    v_exp_f32 v123, v123
    v_exp_f32 v124, v124
    v_exp_f32 v125, v125
    v_exp_f32 v126, v126
    v_exp_f32 v127, v127
    v_cvt_pk_bf16_f32 v128, v120, v121
    v_cvt_pk_bf16_f32 v129, v122, v123
    v_cvt_pk_bf16_f32 v130, v124, v125
    v_cvt_pk_bf16_f32 v131, v126, v127
    ds_write_b128 v59, v[128:131]
    s_add_u32 m0, s91, 57344
    s_add_u32 s56, s90, 0
    buffer_load_dwordx4 v35, s[24:27], s56 offen nt lds
    v_mov_b32 v212, 0x3f803f80
    v_mov_b32 v213, 0x3f803f80
    v_mov_b32 v214, 0x3f803f80
    v_mov_b32 v215, 0x3f803f80
    s_waitcnt lgkmcnt(0)
    s_barrier
    ds_read_b128 v[152:155], v49 offset:0
    ds_read_b128 v[156:159], v49 offset:1024
    ds_read_b128 v[160:163], v49 offset:2048
    ds_read_b128 v[164:167], v49 offset:3072
    s_waitcnt lgkmcnt(3)
    v_mfma_f32_16x16x32_bf16 v[208:211], v[212:215], v[152:155], 0
    s_waitcnt lgkmcnt(2)
    v_mfma_f32_16x16x32_bf16 v[208:211], v[212:215], v[156:159], v[208:211]
    s_waitcnt lgkmcnt(1)
    v_mfma_f32_16x16x32_bf16 v[208:211], v[212:215], v[160:163], v[208:211]
    s_waitcnt lgkmcnt(0)
    v_mfma_f32_16x16x32_bf16 v[208:211], v[212:215], v[164:167], v[208:211]
    s_waitcnt vmcnt(10)
    s_waitcnt vmcnt(9)
    s_waitcnt vmcnt(8)
    s_waitcnt vmcnt(7)
    s_waitcnt vmcnt(6)
    s_add_u32 m0, s91, 61440
    s_add_u32 s56, s90, 16384
    buffer_load_dwordx4 v35, s[24:27], s56 offen nt lds
    s_waitcnt vmcnt(6)
    s_add_u32 m0, s91, 65536
    s_add_u32 s56, s90, 32768
    buffer_load_dwordx4 v35, s[24:27], s56 offen nt lds
    s_waitcnt vmcnt(6)
    s_add_u32 m0, s91, 69632
    s_add_u32 s56, s90, 49152
    buffer_load_dwordx4 v35, s[24:27], s56 offen nt lds
    s_waitcnt vmcnt(6)
    s_add_u32 m0, s93, 49152
    s_add_u32 s56, s92, 0
    buffer_load_dwordx4 v36, s[36:39], s56 offen nt lds
    s_barrier
    ds_read_b64_tr_b16 v[168:169], v41 offset:0
    ds_read_b64_tr_b16 v[170:171], v41 offset:1024
    ds_read_b64_tr_b16 v[184:185], v42 offset:0
    ds_read_b64_tr_b16 v[186:187], v42 offset:1024
    ds_read_b64_tr_b16 v[172:173], v41 offset:8192
    ds_read_b64_tr_b16 v[174:175], v41 offset:9216
    ds_read_b64_tr_b16 v[188:189], v42 offset:8192
    ds_read_b64_tr_b16 v[190:191], v42 offset:9216
    ds_read_b64_tr_b16 v[176:177], v41 offset:16384
    ds_read_b64_tr_b16 v[178:179], v41 offset:17408
    ds_read_b64_tr_b16 v[192:193], v42 offset:16384
    ds_read_b64_tr_b16 v[194:195], v42 offset:17408
    ds_read_b64_tr_b16 v[180:181], v41 offset:24576
    ds_read_b64_tr_b16 v[182:183], v41 offset:25600
    ds_read_b64_tr_b16 v[196:197], v42 offset:24576
    ds_read_b64_tr_b16 v[198:199], v42 offset:25600
    s_add_u32 m0, s93, 50176
    s_add_u32 s56, s100, 0
    buffer_load_dwordx4 v36, s[36:39], s56 offen nt lds
    v_log_f32 v8, v208
    v_rcp_f32 v9, v208
    v_mov_b32 v75, s6
    v_add_f32 v74, v132, v8
    s_waitcnt lgkmcnt(12)
    v_mfma_f32_16x16x32_bf16 v[200:203], v[168:171], v[152:155], 0
    v_mfma_f32_16x16x32_bf16 v[204:207], v[184:187], v[152:155], 0
    s_waitcnt lgkmcnt(8)
    v_mfma_f32_16x16x32_bf16 v[200:203], v[172:175], v[156:159], v[200:203]
    v_mfma_f32_16x16x32_bf16 v[204:207], v[188:191], v[156:159], v[204:207]
    s_waitcnt lgkmcnt(4)
    v_mfma_f32_16x16x32_bf16 v[200:203], v[176:179], v[160:163], v[200:203]
    v_mfma_f32_16x16x32_bf16 v[204:207], v[192:195], v[160:163], v[204:207]
    s_waitcnt lgkmcnt(0)
    v_mfma_f32_16x16x32_bf16 v[200:203], v[180:183], v[164:167], v[200:203]
    v_mfma_f32_16x16x32_bf16 v[204:207], v[196:199], v[164:167], v[204:207]
    s_cmp_eq_u32 s82, 0
    s_nop 6
    v_cndmask_b32 v200, v200, v204, s[98:99]
    v_cndmask_b32 v201, v201, v205, s[98:99]
    v_cndmask_b32 v202, v202, v206, s[98:99]
    v_cndmask_b32 v203, v203, v207, s[98:99]
    v_cndmask_b32 v72, v200, v202, s[96:97]
    v_cndmask_b32 v73, v201, v203, s[96:97]
    v_mul_f32 v72, v72, v9
    v_mul_f32 v73, v73, v9
    s_cbranch_scc1 L_p2far
    buffer_store_dwordx4 v[72:75], v63, s[40:43], s65 offen
    s_branch L_p2done
L_p2far:
    buffer_store_dwordx4 v[72:75], v63, s[40:43], s65 offen sc1
L_p2done:
    s_waitcnt vmcnt(7)
    v_xor_b32 v18, s6, v138
    v_bitop3_b32 v18, v142, v18, s6 bitop3:0xde
    v_cmp_ne_u32 vcc, 0, v18
    s_mov_b32 s7, 0
    s_cbranch_vccz L_ok_f
L_rt_f:
    s_add_u32 s7, s7, 1
    s_cmp_gt_u32 s7, 100000
    s_cbranch_scc1 L_ok_f
    buffer_load_dwordx4 v[136:139], v65, s[40:43], s69 offen sc1
    buffer_load_dwordx4 v[140:143], v65, s[40:43], s70 offen sc1
    s_waitcnt vmcnt(0)
    v_xor_b32 v18, s6, v138
    v_bitop3_b32 v18, v142, v18, s6 bitop3:0xde
    v_cmp_ne_u32 vcc, 0, v18
    s_cbranch_vccnz L_rt_f
L_ok_f:
    v_pk_add_f32 v[120:121], v[136:137], v[140:141]
    s_nop 1
    v_add_f32_dpp v120, v120, v120 row_ror:8 row_mask:0xf bank_mask:0xf
    v_add_f32_dpp v121, v121, v121 row_ror:8 row_mask:0xf bank_mask:0xf
    s_nop 1
    v_permlane16_swap_b32 v120, v121
    v_add_f32 v120, v120, v121
    v_mov_b32 v121, v120
    s_nop 1
    v_permlane32_swap_b32 v120, v121
    v_add_f32 v120, v120, v121
    v_mov_b32 v121, v120
    s_nop 1
    v_permlane16_swap_b32 v120, v121
    v_cvt_pk_bf16_f32 v8, v120, v121
    v_lshlrev_b32 v120, 16, v8
    v_and_b32 v121, 0xffff0000, v8
    v_mul_f32 v8, 0xbfb8aa3b, v120
    v_exp_f32 v8, v8
    s_nop 0
    v_add_f32 v8, 1.0, v8
    v_rcp_f32 v8, v8
    s_nop 0
    v_mul_f32 v8, v120, v8
    v_cvt_pk_bf16_f32 v8, v8, v8
    v_lshlrev_b32 v8, 16, v8
    v_mul_f32 v8, v8, v121
    v_cvt_pk_bf16_f32 v8, v8, v8
    ds_write_b16 v60, v8
    s_waitcnt vmcnt(1)
    buffer_load_dwordx4 v[152:155], v7, s[40:43], s71 offen offset:0 sc1
    buffer_load_dwordx4 v[156:159], v7, s[40:43], s71 offen offset:1024 sc1
    buffer_load_dwordx4 v[160:163], v7, s[40:43], s71 offen offset:2048 sc1
    buffer_load_dwordx4 v[164:167], v7, s[40:43], s71 offen offset:3072 sc1
    s_barrier
    ds_read_b64_tr_b16 v[168:169], v43 offset:24576
    ds_read_b64_tr_b16 v[170:171], v43 offset:25600
    ds_read_b64_tr_b16 v[172:173], v43 offset:32768
    ds_read_b64_tr_b16 v[174:175], v43 offset:33792
    ds_read_b64_tr_b16 v[184:185], v43 offset:16384
    ds_read_b64_tr_b16 v[186:187], v43 offset:17408
    ds_read_b64_tr_b16 v[176:177], v44 offset:24576
    ds_read_b64_tr_b16 v[178:179], v44 offset:25600
    ds_read_b64_tr_b16 v[180:181], v44 offset:32768
    ds_read_b64_tr_b16 v[182:183], v44 offset:33792
    ds_read_b64_tr_b16 v[188:189], v44 offset:16384
    ds_read_b64_tr_b16 v[190:191], v44 offset:17408
    s_waitcnt vmcnt(0)
    v_xor_b32 v18, s6, v155
    v_bitop3_b32 v18, v159, v18, s6 bitop3:0xde
    v_bitop3_b32 v18, v163, v18, s6 bitop3:0xde
    v_bitop3_b32 v18, v167, v18, s6 bitop3:0xde
    v_cmp_ne_u32 vcc, 0, v18
    s_mov_b32 s7, 0
    s_cbranch_vccz L_ok_o
L_rt_o:
    s_add_u32 s7, s7, 1
    s_cmp_gt_u32 s7, 100000
    s_cbranch_scc1 L_ok_o
    buffer_load_dwordx4 v[152:155], v7, s[40:43], s71 offen offset:0 sc1
    buffer_load_dwordx4 v[156:159], v7, s[40:43], s71 offen offset:1024 sc1
    buffer_load_dwordx4 v[160:163], v7, s[40:43], s71 offen offset:2048 sc1
    buffer_load_dwordx4 v[164:167], v7, s[40:43], s71 offen offset:3072 sc1
    s_waitcnt vmcnt(0)
    v_xor_b32 v18, s6, v155
    v_bitop3_b32 v18, v159, v18, s6 bitop3:0xde
    v_bitop3_b32 v18, v163, v18, s6 bitop3:0xde
    v_bitop3_b32 v18, v167, v18, s6 bitop3:0xde
    v_cmp_ne_u32 vcc, 0, v18
    s_cbranch_vccnz L_rt_o
L_ok_o:
    v_max3_f32 v120, v154, v158, v162
    v_max_f32 v120, v120, v166
    s_nop 1
    v_max_f32_dpp v120, v120, v120 row_ror:8 row_mask:0xf bank_mask:0xf
    v_mov_b32 v8, v120
    s_nop 1
    v_permlane16_swap_b32 v120, v8
    v_max_f32 v120, v120, v8
    v_mov_b32 v8, v120
    s_nop 1
    v_permlane32_swap_b32 v120, v8
    v_max_f32 v120, v120, v8
    v_sub_f32 v124, v154, v120
    v_sub_f32 v125, v158, v120
    v_sub_f32 v126, v162, v120
    v_sub_f32 v127, v166, v120
    v_exp_f32 v124, v124
    v_exp_f32 v125, v125
    v_exp_f32 v126, v126
    v_exp_f32 v127, v127
    v_pk_mul_f32 v[122:123], v[152:153], v[124:125] op_sel_hi:[1,0]
    v_pk_add_f32 v[120:121], v[124:125], v[126:127]
    v_pk_fma_f32 v[122:123], v[156:157], v[124:125], v[122:123] op_sel:[0,1,0] op_sel_hi:[1,1,1]
    v_add_f32 v121, v120, v121
    v_pk_fma_f32 v[122:123], v[160:161], v[126:127], v[122:123] op_sel_hi:[1,0,1]
    v_pk_fma_f32 v[122:123], v[164:165], v[126:127], v[122:123] op_sel:[0,1,0] op_sel_hi:[1,1,1]
    v_add_f32_dpp v121, v121, v121 row_ror:8 row_mask:0xf bank_mask:0xf
    s_nop 0
    v_add_f32_dpp v122, v122, v122 row_ror:8 row_mask:0xf bank_mask:0xf
    v_add_f32_dpp v123, v123, v123 row_ror:8 row_mask:0xf bank_mask:0xf
    v_mov_b32 v8, v121
    s_nop 0
    v_permlane16_swap_b32 v122, v123
    v_add_f32 v122, v122, v123
    v_permlane16_swap_b32 v121, v8
    v_mov_b32 v123, v122
    v_add_f32 v121, v121, v8
    v_mov_b32 v8, v121
    v_permlane32_swap_b32 v122, v123
    v_add_f32 v122, v122, v123
    v_permlane32_swap_b32 v121, v8
    v_add_f32 v121, v121, v8
    v_rcp_f32 v121, v121
    s_nop 0
    v_mul_f32 v122, v122, v121
    v_cvt_pk_bf16_f32 v122, v122, v122
    ds_write_b16 v61, v122
    v_cmp_lt_u32 vcc, 15, v1
    v_mov_b32 v194, s6
    v_mov_b32 v195, 0
    s_waitcnt lgkmcnt(0)
    s_barrier
    ds_read_b128 v[152:155], v50
    ds_read_b128 v[160:163], v50 offset:128
    ds_read_b128 v[156:159], v50 offset:64
    s_waitcnt lgkmcnt(2)
    v_mfma_f32_16x16x32_bf16 v[200:203], v[152:155], v[168:171], 0
    v_mfma_f32_16x16x32_bf16 v[204:207], v[152:155], v[176:179], 0
    s_waitcnt lgkmcnt(1)
    v_mfma_f32_16x16x32_bf16 v[208:211], v[160:163], v[184:187], 0
    v_mfma_f32_16x16x32_bf16 v[212:215], v[160:163], v[188:191], 0
    s_waitcnt lgkmcnt(0)
    v_mfma_f32_16x16x32_bf16 v[200:203], v[156:159], v[172:175], v[200:203]
    v_mfma_f32_16x16x32_bf16 v[204:207], v[156:159], v[180:183], v[204:207]
    s_nop 4
    v_cndmask_b32 v193, v208, v212, vcc
    s_nop 1
    v_cndmask_b32 v192, v200, v204, vcc
    s_mov_b32 exec_hi, 0
    buffer_store_dwordx4 v[192:195], v7, s[40:43], s67 offen sc1
    s_mov_b64 exec, -1
    s_cmp_lg_u32 s3, 0
    s_cbranch_scc1 L_fin
    s_cmp_ge_u32 s5, 16
    s_cbranch_scc1 L_fin
    s_waitcnt vmcnt(0)
    buffer_load_dwordx4 v[152:155], v66, s[40:43], s72 offen sc1
    buffer_load_dwordx4 v[156:159], v66, s[40:43], s73 offen sc1
    buffer_load_dwordx4 v[160:163], v66, s[40:43], s74 offen sc1
    buffer_load_dwordx4 v[164:167], v66, s[40:43], s75 offen sc1
    s_waitcnt vmcnt(0)
    v_xor_b32 v18, s6, v154
    v_bitop3_b32 v18, v158, v18, s6 bitop3:0xde
    v_bitop3_b32 v18, v162, v18, s6 bitop3:0xde
    v_bitop3_b32 v18, v166, v18, s6 bitop3:0xde
    v_cmp_ne_u32 vcc, 0, v18
    s_mov_b32 s7, 0
    s_cbranch_vccz L_ok_z
L_rt_z:
    s_add_u32 s7, s7, 1
    s_cmp_gt_u32 s7, 100000
    s_cbranch_scc1 L_ok_z
    buffer_load_dwordx4 v[152:155], v66, s[40:43], s72 offen sc1
    buffer_load_dwordx4 v[156:159], v66, s[40:43], s73 offen sc1
    buffer_load_dwordx4 v[160:163], v66, s[40:43], s74 offen sc1
    buffer_load_dwordx4 v[164:167], v66, s[40:43], s75 offen sc1
    s_waitcnt vmcnt(0)
    v_xor_b32 v18, s6, v154
    v_bitop3_b32 v18, v158, v18, s6 bitop3:0xde
    v_bitop3_b32 v18, v162, v18, s6 bitop3:0xde
    v_bitop3_b32 v18, v166, v18, s6 bitop3:0xde
    v_cmp_ne_u32 vcc, 0, v18
    s_cbranch_vccnz L_rt_z
L_ok_z:
    v_pk_add_f32 v[120:121], v[152:153], v[156:157]
    v_pk_add_f32 v[122:123], v[160:161], v[164:165]
    v_lshlrev_b32 v16, 16, v16
    v_pk_add_f32 v[120:121], v[120:121], v[122:123]
    s_lshl_b32 s54, s95, 3
    v_lshlrev_b32 v9, 1, v5
    v_add_f32_dpp v120, v120, v120 row_ror:4 row_mask:0xf bank_mask:0xf
    v_add_f32_dpp v121, v121, v121 row_ror:4 row_mask:0xf bank_mask:0xf
    s_nop 0
    v_add_f32_dpp v120, v120, v120 row_ror:8 row_mask:0xf bank_mask:0xf
    v_add_f32_dpp v121, v121, v121 row_ror:8 row_mask:0xf bank_mask:0xf
    s_nop 1
    v_permlane16_swap_b32 v120, v121
    v_add_f32 v120, v120, v121
    v_mov_b32 v121, v120
    s_nop 1
    v_permlane32_swap_b32 v120, v121
    v_add_f32 v120, v120, v121
    v_mov_b32 v121, v120
    s_nop 1
    v_permlane16_swap_b32 v120, v121
    v_cvt_pk_bf16_f32 v8, v120, v121
    v_lshlrev_b32 v120, 16, v8
    v_and_b32 v121, 0xffff0000, v8
    v_add_f32 v120, v16, v120
    v_cvt_pk_bf16_f32 v120, v120, v120
    v_lshlrev_b32 v120, 16, v120
    v_add_f32 v120, v120, v121
    v_cvt_pk_bf16_f32 v120, v120, v120
    s_mov_b64 exec, 15
    buffer_store_short v120, v9, s[44:47], s54 offen sc1
    s_mov_b64 exec, -1
    s_cmp_lg_u32 s2, 0
    s_cbranch_scc1 L_fin
    v_mov_b32 v8, 0
    v_mov_b32 v9, s6
    s_mov_b64 exec, 1
    buffer_store_dword v9, v8, s[40:43], 0 offen sc1
    s_mov_b64 exec, -1
L_fin:
L_end:
    s_endpgm
.section .rodata,"a"
.p2align 6
.amdhsa_kernel parallel_sum__sliding_block_cached__swiglu_ffn__decode_kernel
  .amdhsa_next_free_vgpr 216
  .amdhsa_next_free_sgpr 102
  .amdhsa_accum_offset 216
  .amdhsa_group_segment_fixed_size 0
  .amdhsa_kernarg_size 96
  .amdhsa_user_sgpr_count 2
  .amdhsa_user_sgpr_kernarg_segment_ptr 1
  .amdhsa_system_sgpr_workgroup_id_x 1
.end_amdhsa_kernel
```
